```python
import torch

def _softmax(x, axis=-1):
    return torch.softmax(x, dim=axis)
def _gelu(x):
    return torch.nn.functional.gelu(x, approximate="tanh")
def _silu(x):
    return torch.nn.functional.silu(x)
def _sigmoid(x):
    return torch.sigmoid(x)
def _layernorm(x, axis=-1, eps=1e-5):
    m = x.mean(dim=axis, keepdim=True)
    v = x.var(dim=axis, keepdim=True, unbiased=False)
    return (x - m) / torch.sqrt(v + eps)
def _scatter_add(tgt, idx, src, axis=0):
    return tgt.clone().index_add_(axis, idx, src)
def _segment_sum(src, seg, n):
    out = torch.zeros((n,) + src.shape[1:], dtype=src.dtype)
    return out.index_add_(0, seg, src)
def _pad(x, pw):
    flat = tuple(v for pair in reversed(pw) for v in pair)
    return torch.nn.functional.pad(x, flat)

kernel_name = 'standalone__instancenorm__prompt'

def setup_inputs():

    _w = (lambda a: (lambda t: t.to(torch.bfloat16) if t.is_floating_point() else t)(torch.as_tensor(a)))
    B, C, H, W = 2, 448, 2048, 16
    return {
        "x": _w(abs((lambda *s: torch.randn(*s, dtype=torch.bfloat16) * 0.05)(B, C, H, W))),
        "g": _w((lambda *s: torch.randn(*s, dtype=torch.bfloat16) * 0.05)(C) + 1.0),
        "b": _w((lambda *s: torch.randn(*s, dtype=torch.bfloat16) * 0.4)(C)),
    }

def reference(x, g, b):
    mu = x.mean(axis=(-2, -1), keepdims=True)
    var = ((x - mu) ** 2).mean(axis=(-2, -1), keepdims=True)
    xhat = (x - mu) / torch.sqrt(var + 1e-5)
    return xhat * g.reshape(1, -1, 1, 1) + b.reshape(1, -1, 1, 1)
```

```asm
; @launch grid=(448,1,1) block=(256,1,1) lds=32
.amdgcn_target "amdgcn-amd-amdhsa--gfx950"
.text
.globl standalone__instancenorm__prompt_kernel
.p2align 8
.type standalone__instancenorm__prompt_kernel,@function
standalone__instancenorm__prompt_kernel:
    s_cmp_ge_u32 s2, 448
    s_cbranch_scc1 L_end
    s_load_dwordx4 s[4:7], s[0:1], 0
    s_load_dwordx4 s[8:11], s[0:1], 16
    v_readfirstlane_b32 s30, v0
    v_lshrrev_b32 v2, 6, v0
    v_and_b32 v1, 127, v0
    v_lshlrev_b32 v1, 4, v1
    v_lshrrev_b32 v3, 7, v0
    v_lshlrev_b32 v3, 4, v3
    v_lshlrev_b32 v2, 3, v2
    s_lshr_b32 s31, s30, 7
    s_mul_i32 s3, s2, 2
    s_add_u32 s3, s3, s31
    s_cmp_ge_u32 s3, 896
    s_cbranch_scc1 L_end
    s_lshl_b32 s20, s3, 16
    v_add_u32 v1, s20, v1
    s_sub_u32 s21, s3, 448
    s_cmp_ge_u32 s3, 448
    s_cselect_b32 s21, s21, s3
    s_lshr_b32 s22, s21, 1
    s_lshl_b32 s22, s22, 2
    s_min_u32 s22, s22, 892
    s_waitcnt lgkmcnt(0)
    s_mov_b32 s12, s4
    s_and_b32 s13, s5, 0xffff
    s_mov_b32 s14, 58720256
    s_mov_b32 s15, 0x00020000
    s_mov_b32 s16, s10
    s_and_b32 s17, s11, 0xffff
    s_mov_b32 s18, 58720256
    s_mov_b32 s19, 0x00020000
    s_buffer_load_dword s32, s[12:15], s20
    s_load_dword s23, s[6:7], s22
    s_load_dword s24, s[8:9], s22
    s_mov_b32 s40, 0
    s_mov_b32 s41, 4096
    s_mov_b32 s42, 8192
    s_mov_b32 s43, 12288
    s_mov_b32 s44, 16384
    s_mov_b32 s45, 20480
    s_mov_b32 s46, 24576
    s_mov_b32 s47, 28672
    s_mov_b32 s48, 32768
    s_mov_b32 s49, 36864
    s_mov_b32 s50, 40960
    s_mov_b32 s51, 45056
    s_mov_b32 s52, 49152
    s_mov_b32 s53, 53248
    s_mov_b32 s54, 57344
    s_mov_b32 s55, 61440
    buffer_load_dwordx4 v[4:7], v1, s[12:15], s40 offen offset:0 nt
    buffer_load_dwordx4 v[8:11], v1, s[12:15], s40 offen offset:2048 nt
    buffer_load_dwordx4 v[12:15], v1, s[12:15], s41 offen offset:0 nt
    buffer_load_dwordx4 v[16:19], v1, s[12:15], s41 offen offset:2048 nt
    buffer_load_dwordx4 v[20:23], v1, s[12:15], s42 offen offset:0 nt
    buffer_load_dwordx4 v[24:27], v1, s[12:15], s42 offen offset:2048 nt
    buffer_load_dwordx4 v[28:31], v1, s[12:15], s43 offen offset:0 nt
    buffer_load_dwordx4 v[32:35], v1, s[12:15], s43 offen offset:2048 nt
    buffer_load_dwordx4 v[36:39], v1, s[12:15], s44 offen offset:0 nt
    buffer_load_dwordx4 v[40:43], v1, s[12:15], s44 offen offset:2048 nt
    buffer_load_dwordx4 v[44:47], v1, s[12:15], s45 offen offset:0 nt
    buffer_load_dwordx4 v[48:51], v1, s[12:15], s45 offen offset:2048 nt
    buffer_load_dwordx4 v[52:55], v1, s[12:15], s46 offen offset:0 nt
    buffer_load_dwordx4 v[56:59], v1, s[12:15], s46 offen offset:2048 nt
    buffer_load_dwordx4 v[60:63], v1, s[12:15], s47 offen offset:0 nt
    buffer_load_dwordx4 v[64:67], v1, s[12:15], s47 offen offset:2048 nt
    buffer_load_dwordx4 v[68:71], v1, s[12:15], s48 offen offset:0 nt
    buffer_load_dwordx4 v[72:75], v1, s[12:15], s48 offen offset:2048 nt
    buffer_load_dwordx4 v[76:79], v1, s[12:15], s49 offen offset:0 nt
    buffer_load_dwordx4 v[80:83], v1, s[12:15], s49 offen offset:2048 nt
    buffer_load_dwordx4 v[84:87], v1, s[12:15], s50 offen offset:0 nt
    buffer_load_dwordx4 v[88:91], v1, s[12:15], s50 offen offset:2048 nt
    buffer_load_dwordx4 v[92:95], v1, s[12:15], s51 offen offset:0 nt
    buffer_load_dwordx4 v[96:99], v1, s[12:15], s51 offen offset:2048 nt
    buffer_load_dwordx4 v[100:103], v1, s[12:15], s52 offen offset:0 nt
    buffer_load_dwordx4 v[104:107], v1, s[12:15], s52 offen offset:2048 nt
    buffer_load_dwordx4 v[108:111], v1, s[12:15], s53 offen offset:0 nt
    buffer_load_dwordx4 v[112:115], v1, s[12:15], s53 offen offset:2048 nt
    buffer_load_dwordx4 v[116:119], v1, s[12:15], s54 offen offset:0 nt
    buffer_load_dwordx4 v[120:123], v1, s[12:15], s54 offen offset:2048 nt
    buffer_load_dwordx4 v[124:127], v1, s[12:15], s55 offen offset:0 nt
    buffer_load_dwordx4 v[128:131], v1, s[12:15], s55 offen offset:2048 nt
    v_mov_b32 v132, 0
    v_mov_b32 v133, 0
    v_mov_b32 v134, 0
    v_mov_b32 v135, 0
    s_waitcnt lgkmcnt(0)
    s_lshl_b32 s32, s32, 16
    s_xor_b32 s34, s32, 0x80000000
    s_mov_b32 s35, s34
    s_lshl_b32 s26, s23, 16
    s_and_b32 s27, s23, 0xffff0000
    s_lshl_b32 s28, s24, 16
    s_and_b32 s29, s24, 0xffff0000
    s_and_b32 s25, s21, 1
    s_cmp_eq_u32 s25, 1
    s_cselect_b32 s26, s27, s26
    s_cselect_b32 s28, s29, s28
    s_waitcnt vmcnt(31)
    v_lshlrev_b32 v136, 16, v4
    v_and_b32 v137, 0xffff0000, v4
    v_pk_add_f32 v[136:137], v[136:137], s[34:35]
    v_pk_add_f32 v[132:133], v[132:133], v[136:137]
    v_pk_fma_f32 v[134:135], v[136:137], v[136:137], v[134:135]
    v_lshlrev_b32 v138, 16, v5
    v_and_b32 v139, 0xffff0000, v5
    v_pk_add_f32 v[138:139], v[138:139], s[34:35]
    v_pk_add_f32 v[132:133], v[132:133], v[138:139]
    v_pk_fma_f32 v[134:135], v[138:139], v[138:139], v[134:135]
    v_lshlrev_b32 v136, 16, v6
    v_and_b32 v137, 0xffff0000, v6
    v_pk_add_f32 v[136:137], v[136:137], s[34:35]
    v_pk_add_f32 v[132:133], v[132:133], v[136:137]
    v_pk_fma_f32 v[134:135], v[136:137], v[136:137], v[134:135]
    v_lshlrev_b32 v138, 16, v7
    v_and_b32 v139, 0xffff0000, v7
    v_pk_add_f32 v[138:139], v[138:139], s[34:35]
    v_pk_add_f32 v[132:133], v[132:133], v[138:139]
    v_pk_fma_f32 v[134:135], v[138:139], v[138:139], v[134:135]
    s_waitcnt vmcnt(30)
    v_lshlrev_b32 v136, 16, v8
    v_and_b32 v137, 0xffff0000, v8
    v_pk_add_f32 v[136:137], v[136:137], s[34:35]
    v_pk_add_f32 v[132:133], v[132:133], v[136:137]
    v_pk_fma_f32 v[134:135], v[136:137], v[136:137], v[134:135]
    v_lshlrev_b32 v138, 16, v9
    v_and_b32 v139, 0xffff0000, v9
    v_pk_add_f32 v[138:139], v[138:139], s[34:35]
    v_pk_add_f32 v[132:133], v[132:133], v[138:139]
    v_pk_fma_f32 v[134:135], v[138:139], v[138:139], v[134:135]
    v_lshlrev_b32 v136, 16, v10
    v_and_b32 v137, 0xffff0000, v10
    v_pk_add_f32 v[136:137], v[136:137], s[34:35]
    v_pk_add_f32 v[132:133], v[132:133], v[136:137]
    v_pk_fma_f32 v[134:135], v[136:137], v[136:137], v[134:135]
    v_lshlrev_b32 v138, 16, v11
    v_and_b32 v139, 0xffff0000, v11
    v_pk_add_f32 v[138:139], v[138:139], s[34:35]
    v_pk_add_f32 v[132:133], v[132:133], v[138:139]
    v_pk_fma_f32 v[134:135], v[138:139], v[138:139], v[134:135]
    s_waitcnt vmcnt(29)
    v_lshlrev_b32 v136, 16, v12
    v_and_b32 v137, 0xffff0000, v12
    v_pk_add_f32 v[136:137], v[136:137], s[34:35]
    v_pk_add_f32 v[132:133], v[132:133], v[136:137]
    v_pk_fma_f32 v[134:135], v[136:137], v[136:137], v[134:135]
    v_lshlrev_b32 v138, 16, v13
    v_and_b32 v139, 0xffff0000, v13
    v_pk_add_f32 v[138:139], v[138:139], s[34:35]
    v_pk_add_f32 v[132:133], v[132:133], v[138:139]
    v_pk_fma_f32 v[134:135], v[138:139], v[138:139], v[134:135]
    v_lshlrev_b32 v136, 16, v14
    v_and_b32 v137, 0xffff0000, v14
    v_pk_add_f32 v[136:137], v[136:137], s[34:35]
    v_pk_add_f32 v[132:133], v[132:133], v[136:137]
    v_pk_fma_f32 v[134:135], v[136:137], v[136:137], v[134:135]
    v_lshlrev_b32 v138, 16, v15
    v_and_b32 v139, 0xffff0000, v15
    v_pk_add_f32 v[138:139], v[138:139], s[34:35]
    v_pk_add_f32 v[132:133], v[132:133], v[138:139]
    v_pk_fma_f32 v[134:135], v[138:139], v[138:139], v[134:135]
    s_waitcnt vmcnt(28)
    v_lshlrev_b32 v136, 16, v16
    v_and_b32 v137, 0xffff0000, v16
    v_pk_add_f32 v[136:137], v[136:137], s[34:35]
    v_pk_add_f32 v[132:133], v[132:133], v[136:137]
    v_pk_fma_f32 v[134:135], v[136:137], v[136:137], v[134:135]
    v_lshlrev_b32 v138, 16, v17
    v_and_b32 v139, 0xffff0000, v17
    v_pk_add_f32 v[138:139], v[138:139], s[34:35]
    v_pk_add_f32 v[132:133], v[132:133], v[138:139]
    v_pk_fma_f32 v[134:135], v[138:139], v[138:139], v[134:135]
    v_lshlrev_b32 v136, 16, v18
    v_and_b32 v137, 0xffff0000, v18
    v_pk_add_f32 v[136:137], v[136:137], s[34:35]
    v_pk_add_f32 v[132:133], v[132:133], v[136:137]
    v_pk_fma_f32 v[134:135], v[136:137], v[136:137], v[134:135]
    v_lshlrev_b32 v138, 16, v19
    v_and_b32 v139, 0xffff0000, v19
    v_pk_add_f32 v[138:139], v[138:139], s[34:35]
    v_pk_add_f32 v[132:133], v[132:133], v[138:139]
    v_pk_fma_f32 v[134:135], v[138:139], v[138:139], v[134:135]
    s_waitcnt vmcnt(27)
    v_lshlrev_b32 v136, 16, v20
    v_and_b32 v137, 0xffff0000, v20
    v_pk_add_f32 v[136:137], v[136:137], s[34:35]
    v_pk_add_f32 v[132:133], v[132:133], v[136:137]
    v_pk_fma_f32 v[134:135], v[136:137], v[136:137], v[134:135]
    v_lshlrev_b32 v138, 16, v21
    v_and_b32 v139, 0xffff0000, v21
    v_pk_add_f32 v[138:139], v[138:139], s[34:35]
    v_pk_add_f32 v[132:133], v[132:133], v[138:139]
    v_pk_fma_f32 v[134:135], v[138:139], v[138:139], v[134:135]
    v_lshlrev_b32 v136, 16, v22
    v_and_b32 v137, 0xffff0000, v22
    v_pk_add_f32 v[136:137], v[136:137], s[34:35]
    v_pk_add_f32 v[132:133], v[132:133], v[136:137]
    v_pk_fma_f32 v[134:135], v[136:137], v[136:137], v[134:135]
    v_lshlrev_b32 v138, 16, v23
    v_and_b32 v139, 0xffff0000, v23
    v_pk_add_f32 v[138:139], v[138:139], s[34:35]
    v_pk_add_f32 v[132:133], v[132:133], v[138:139]
    v_pk_fma_f32 v[134:135], v[138:139], v[138:139], v[134:135]
    s_waitcnt vmcnt(26)
    v_lshlrev_b32 v136, 16, v24
    v_and_b32 v137, 0xffff0000, v24
    v_pk_add_f32 v[136:137], v[136:137], s[34:35]
    v_pk_add_f32 v[132:133], v[132:133], v[136:137]
    v_pk_fma_f32 v[134:135], v[136:137], v[136:137], v[134:135]
    v_lshlrev_b32 v138, 16, v25
    v_and_b32 v139, 0xffff0000, v25
    v_pk_add_f32 v[138:139], v[138:139], s[34:35]
    v_pk_add_f32 v[132:133], v[132:133], v[138:139]
    v_pk_fma_f32 v[134:135], v[138:139], v[138:139], v[134:135]
    v_lshlrev_b32 v136, 16, v26
    v_and_b32 v137, 0xffff0000, v26
    v_pk_add_f32 v[136:137], v[136:137], s[34:35]
    v_pk_add_f32 v[132:133], v[132:133], v[136:137]
    v_pk_fma_f32 v[134:135], v[136:137], v[136:137], v[134:135]
    v_lshlrev_b32 v138, 16, v27
    v_and_b32 v139, 0xffff0000, v27
    v_pk_add_f32 v[138:139], v[138:139], s[34:35]
    v_pk_add_f32 v[132:133], v[132:133], v[138:139]
    v_pk_fma_f32 v[134:135], v[138:139], v[138:139], v[134:135]
    s_waitcnt vmcnt(25)
    v_lshlrev_b32 v136, 16, v28
    v_and_b32 v137, 0xffff0000, v28
    v_pk_add_f32 v[136:137], v[136:137], s[34:35]
    v_pk_add_f32 v[132:133], v[132:133], v[136:137]
    v_pk_fma_f32 v[134:135], v[136:137], v[136:137], v[134:135]
    v_lshlrev_b32 v138, 16, v29
    v_and_b32 v139, 0xffff0000, v29
    v_pk_add_f32 v[138:139], v[138:139], s[34:35]
    v_pk_add_f32 v[132:133], v[132:133], v[138:139]
    v_pk_fma_f32 v[134:135], v[138:139], v[138:139], v[134:135]
    v_lshlrev_b32 v136, 16, v30
    v_and_b32 v137, 0xffff0000, v30
    v_pk_add_f32 v[136:137], v[136:137], s[34:35]
    v_pk_add_f32 v[132:133], v[132:133], v[136:137]
    v_pk_fma_f32 v[134:135], v[136:137], v[136:137], v[134:135]
    v_lshlrev_b32 v138, 16, v31
    v_and_b32 v139, 0xffff0000, v31
    v_pk_add_f32 v[138:139], v[138:139], s[34:35]
    v_pk_add_f32 v[132:133], v[132:133], v[138:139]
    v_pk_fma_f32 v[134:135], v[138:139], v[138:139], v[134:135]
    s_waitcnt vmcnt(24)
    v_lshlrev_b32 v136, 16, v32
    v_and_b32 v137, 0xffff0000, v32
    v_pk_add_f32 v[136:137], v[136:137], s[34:35]
    v_pk_add_f32 v[132:133], v[132:133], v[136:137]
    v_pk_fma_f32 v[134:135], v[136:137], v[136:137], v[134:135]
    v_lshlrev_b32 v138, 16, v33
    v_and_b32 v139, 0xffff0000, v33
    v_pk_add_f32 v[138:139], v[138:139], s[34:35]
    v_pk_add_f32 v[132:133], v[132:133], v[138:139]
    v_pk_fma_f32 v[134:135], v[138:139], v[138:139], v[134:135]
    v_lshlrev_b32 v136, 16, v34
    v_and_b32 v137, 0xffff0000, v34
    v_pk_add_f32 v[136:137], v[136:137], s[34:35]
    v_pk_add_f32 v[132:133], v[132:133], v[136:137]
    v_pk_fma_f32 v[134:135], v[136:137], v[136:137], v[134:135]
    v_lshlrev_b32 v138, 16, v35
    v_and_b32 v139, 0xffff0000, v35
    v_pk_add_f32 v[138:139], v[138:139], s[34:35]
    v_pk_add_f32 v[132:133], v[132:133], v[138:139]
    v_pk_fma_f32 v[134:135], v[138:139], v[138:139], v[134:135]
    s_waitcnt vmcnt(23)
    v_lshlrev_b32 v136, 16, v36
    v_and_b32 v137, 0xffff0000, v36
    v_pk_add_f32 v[136:137], v[136:137], s[34:35]
    v_pk_add_f32 v[132:133], v[132:133], v[136:137]
    v_pk_fma_f32 v[134:135], v[136:137], v[136:137], v[134:135]
    v_lshlrev_b32 v138, 16, v37
    v_and_b32 v139, 0xffff0000, v37
    v_pk_add_f32 v[138:139], v[138:139], s[34:35]
    v_pk_add_f32 v[132:133], v[132:133], v[138:139]
    v_pk_fma_f32 v[134:135], v[138:139], v[138:139], v[134:135]
    v_lshlrev_b32 v136, 16, v38
    v_and_b32 v137, 0xffff0000, v38
    v_pk_add_f32 v[136:137], v[136:137], s[34:35]
    v_pk_add_f32 v[132:133], v[132:133], v[136:137]
    v_pk_fma_f32 v[134:135], v[136:137], v[136:137], v[134:135]
    v_lshlrev_b32 v138, 16, v39
    v_and_b32 v139, 0xffff0000, v39
    v_pk_add_f32 v[138:139], v[138:139], s[34:35]
    v_pk_add_f32 v[132:133], v[132:133], v[138:139]
    v_pk_fma_f32 v[134:135], v[138:139], v[138:139], v[134:135]
    s_waitcnt vmcnt(22)
    v_lshlrev_b32 v136, 16, v40
    v_and_b32 v137, 0xffff0000, v40
    v_pk_add_f32 v[136:137], v[136:137], s[34:35]
    v_pk_add_f32 v[132:133], v[132:133], v[136:137]
    v_pk_fma_f32 v[134:135], v[136:137], v[136:137], v[134:135]
    v_lshlrev_b32 v138, 16, v41
    v_and_b32 v139, 0xffff0000, v41
    v_pk_add_f32 v[138:139], v[138:139], s[34:35]
    v_pk_add_f32 v[132:133], v[132:133], v[138:139]
    v_pk_fma_f32 v[134:135], v[138:139], v[138:139], v[134:135]
    v_lshlrev_b32 v136, 16, v42
    v_and_b32 v137, 0xffff0000, v42
    v_pk_add_f32 v[136:137], v[136:137], s[34:35]
    v_pk_add_f32 v[132:133], v[132:133], v[136:137]
    v_pk_fma_f32 v[134:135], v[136:137], v[136:137], v[134:135]
    v_lshlrev_b32 v138, 16, v43
    v_and_b32 v139, 0xffff0000, v43
    v_pk_add_f32 v[138:139], v[138:139], s[34:35]
    v_pk_add_f32 v[132:133], v[132:133], v[138:139]
    v_pk_fma_f32 v[134:135], v[138:139], v[138:139], v[134:135]
    s_waitcnt vmcnt(21)
    v_lshlrev_b32 v136, 16, v44
    v_and_b32 v137, 0xffff0000, v44
    v_pk_add_f32 v[136:137], v[136:137], s[34:35]
    v_pk_add_f32 v[132:133], v[132:133], v[136:137]
    v_pk_fma_f32 v[134:135], v[136:137], v[136:137], v[134:135]
    v_lshlrev_b32 v138, 16, v45
    v_and_b32 v139, 0xffff0000, v45
    v_pk_add_f32 v[138:139], v[138:139], s[34:35]
    v_pk_add_f32 v[132:133], v[132:133], v[138:139]
    v_pk_fma_f32 v[134:135], v[138:139], v[138:139], v[134:135]
    v_lshlrev_b32 v136, 16, v46
    v_and_b32 v137, 0xffff0000, v46
    v_pk_add_f32 v[136:137], v[136:137], s[34:35]
    v_pk_add_f32 v[132:133], v[132:133], v[136:137]
    v_pk_fma_f32 v[134:135], v[136:137], v[136:137], v[134:135]
    v_lshlrev_b32 v138, 16, v47
    v_and_b32 v139, 0xffff0000, v47
    v_pk_add_f32 v[138:139], v[138:139], s[34:35]
    v_pk_add_f32 v[132:133], v[132:133], v[138:139]
    v_pk_fma_f32 v[134:135], v[138:139], v[138:139], v[134:135]
    s_waitcnt vmcnt(20)
    v_lshlrev_b32 v136, 16, v48
    v_and_b32 v137, 0xffff0000, v48
    v_pk_add_f32 v[136:137], v[136:137], s[34:35]
    v_pk_add_f32 v[132:133], v[132:133], v[136:137]
    v_pk_fma_f32 v[134:135], v[136:137], v[136:137], v[134:135]
    v_lshlrev_b32 v138, 16, v49
    v_and_b32 v139, 0xffff0000, v49
    v_pk_add_f32 v[138:139], v[138:139], s[34:35]
    v_pk_add_f32 v[132:133], v[132:133], v[138:139]
    v_pk_fma_f32 v[134:135], v[138:139], v[138:139], v[134:135]
    v_lshlrev_b32 v136, 16, v50
    v_and_b32 v137, 0xffff0000, v50
    v_pk_add_f32 v[136:137], v[136:137], s[34:35]
    v_pk_add_f32 v[132:133], v[132:133], v[136:137]
    v_pk_fma_f32 v[134:135], v[136:137], v[136:137], v[134:135]
    v_lshlrev_b32 v138, 16, v51
    v_and_b32 v139, 0xffff0000, v51
    v_pk_add_f32 v[138:139], v[138:139], s[34:35]
    v_pk_add_f32 v[132:133], v[132:133], v[138:139]
    v_pk_fma_f32 v[134:135], v[138:139], v[138:139], v[134:135]
    s_waitcnt vmcnt(19)
    v_lshlrev_b32 v136, 16, v52
    v_and_b32 v137, 0xffff0000, v52
    v_pk_add_f32 v[136:137], v[136:137], s[34:35]
    v_pk_add_f32 v[132:133], v[132:133], v[136:137]
    v_pk_fma_f32 v[134:135], v[136:137], v[136:137], v[134:135]
    v_lshlrev_b32 v138, 16, v53
    v_and_b32 v139, 0xffff0000, v53
    v_pk_add_f32 v[138:139], v[138:139], s[34:35]
    v_pk_add_f32 v[132:133], v[132:133], v[138:139]
    v_pk_fma_f32 v[134:135], v[138:139], v[138:139], v[134:135]
    v_lshlrev_b32 v136, 16, v54
    v_and_b32 v137, 0xffff0000, v54
    v_pk_add_f32 v[136:137], v[136:137], s[34:35]
    v_pk_add_f32 v[132:133], v[132:133], v[136:137]
    v_pk_fma_f32 v[134:135], v[136:137], v[136:137], v[134:135]
    v_lshlrev_b32 v138, 16, v55
    v_and_b32 v139, 0xffff0000, v55
    v_pk_add_f32 v[138:139], v[138:139], s[34:35]
    v_pk_add_f32 v[132:133], v[132:133], v[138:139]
    v_pk_fma_f32 v[134:135], v[138:139], v[138:139], v[134:135]
    s_waitcnt vmcnt(18)
    v_lshlrev_b32 v136, 16, v56
    v_and_b32 v137, 0xffff0000, v56
    v_pk_add_f32 v[136:137], v[136:137], s[34:35]
    v_pk_add_f32 v[132:133], v[132:133], v[136:137]
    v_pk_fma_f32 v[134:135], v[136:137], v[136:137], v[134:135]
    v_lshlrev_b32 v138, 16, v57
    v_and_b32 v139, 0xffff0000, v57
    v_pk_add_f32 v[138:139], v[138:139], s[34:35]
    v_pk_add_f32 v[132:133], v[132:133], v[138:139]
    v_pk_fma_f32 v[134:135], v[138:139], v[138:139], v[134:135]
    v_lshlrev_b32 v136, 16, v58
    v_and_b32 v137, 0xffff0000, v58
    v_pk_add_f32 v[136:137], v[136:137], s[34:35]
    v_pk_add_f32 v[132:133], v[132:133], v[136:137]
    v_pk_fma_f32 v[134:135], v[136:137], v[136:137], v[134:135]
    v_lshlrev_b32 v138, 16, v59
    v_and_b32 v139, 0xffff0000, v59
    v_pk_add_f32 v[138:139], v[138:139], s[34:35]
    v_pk_add_f32 v[132:133], v[132:133], v[138:139]
    v_pk_fma_f32 v[134:135], v[138:139], v[138:139], v[134:135]
    s_waitcnt vmcnt(17)
    v_lshlrev_b32 v136, 16, v60
    v_and_b32 v137, 0xffff0000, v60
    v_pk_add_f32 v[136:137], v[136:137], s[34:35]
    v_pk_add_f32 v[132:133], v[132:133], v[136:137]
    v_pk_fma_f32 v[134:135], v[136:137], v[136:137], v[134:135]
    v_lshlrev_b32 v138, 16, v61
    v_and_b32 v139, 0xffff0000, v61
    v_pk_add_f32 v[138:139], v[138:139], s[34:35]
    v_pk_add_f32 v[132:133], v[132:133], v[138:139]
    v_pk_fma_f32 v[134:135], v[138:139], v[138:139], v[134:135]
    v_lshlrev_b32 v136, 16, v62
    v_and_b32 v137, 0xffff0000, v62
    v_pk_add_f32 v[136:137], v[136:137], s[34:35]
    v_pk_add_f32 v[132:133], v[132:133], v[136:137]
    v_pk_fma_f32 v[134:135], v[136:137], v[136:137], v[134:135]
    v_lshlrev_b32 v138, 16, v63
    v_and_b32 v139, 0xffff0000, v63
    v_pk_add_f32 v[138:139], v[138:139], s[34:35]
    v_pk_add_f32 v[132:133], v[132:133], v[138:139]
    v_pk_fma_f32 v[134:135], v[138:139], v[138:139], v[134:135]
    s_waitcnt vmcnt(16)
    v_lshlrev_b32 v136, 16, v64
    v_and_b32 v137, 0xffff0000, v64
    v_pk_add_f32 v[136:137], v[136:137], s[34:35]
    v_pk_add_f32 v[132:133], v[132:133], v[136:137]
    v_pk_fma_f32 v[134:135], v[136:137], v[136:137], v[134:135]
    v_lshlrev_b32 v138, 16, v65
    v_and_b32 v139, 0xffff0000, v65
    v_pk_add_f32 v[138:139], v[138:139], s[34:35]
    v_pk_add_f32 v[132:133], v[132:133], v[138:139]
    v_pk_fma_f32 v[134:135], v[138:139], v[138:139], v[134:135]
    v_lshlrev_b32 v136, 16, v66
    v_and_b32 v137, 0xffff0000, v66
    v_pk_add_f32 v[136:137], v[136:137], s[34:35]
    v_pk_add_f32 v[132:133], v[132:133], v[136:137]
    v_pk_fma_f32 v[134:135], v[136:137], v[136:137], v[134:135]
    v_lshlrev_b32 v138, 16, v67
    v_and_b32 v139, 0xffff0000, v67
    v_pk_add_f32 v[138:139], v[138:139], s[34:35]
    v_pk_add_f32 v[132:133], v[132:133], v[138:139]
    v_pk_fma_f32 v[134:135], v[138:139], v[138:139], v[134:135]
    s_waitcnt vmcnt(15)
    v_lshlrev_b32 v136, 16, v68
    v_and_b32 v137, 0xffff0000, v68
    v_pk_add_f32 v[136:137], v[136:137], s[34:35]
    v_pk_add_f32 v[132:133], v[132:133], v[136:137]
    v_pk_fma_f32 v[134:135], v[136:137], v[136:137], v[134:135]
    v_lshlrev_b32 v138, 16, v69
    v_and_b32 v139, 0xffff0000, v69
    v_pk_add_f32 v[138:139], v[138:139], s[34:35]
    v_pk_add_f32 v[132:133], v[132:133], v[138:139]
    v_pk_fma_f32 v[134:135], v[138:139], v[138:139], v[134:135]
    v_lshlrev_b32 v136, 16, v70
    v_and_b32 v137, 0xffff0000, v70
    v_pk_add_f32 v[136:137], v[136:137], s[34:35]
    v_pk_add_f32 v[132:133], v[132:133], v[136:137]
    v_pk_fma_f32 v[134:135], v[136:137], v[136:137], v[134:135]
    v_lshlrev_b32 v138, 16, v71
    v_and_b32 v139, 0xffff0000, v71
    v_pk_add_f32 v[138:139], v[138:139], s[34:35]
    v_pk_add_f32 v[132:133], v[132:133], v[138:139]
    v_pk_fma_f32 v[134:135], v[138:139], v[138:139], v[134:135]
    s_waitcnt vmcnt(14)
    v_lshlrev_b32 v136, 16, v72
    v_and_b32 v137, 0xffff0000, v72
    v_pk_add_f32 v[136:137], v[136:137], s[34:35]
    v_pk_add_f32 v[132:133], v[132:133], v[136:137]
    v_pk_fma_f32 v[134:135], v[136:137], v[136:137], v[134:135]
    v_lshlrev_b32 v138, 16, v73
    v_and_b32 v139, 0xffff0000, v73
    v_pk_add_f32 v[138:139], v[138:139], s[34:35]
    v_pk_add_f32 v[132:133], v[132:133], v[138:139]
    v_pk_fma_f32 v[134:135], v[138:139], v[138:139], v[134:135]
    v_lshlrev_b32 v136, 16, v74
    v_and_b32 v137, 0xffff0000, v74
    v_pk_add_f32 v[136:137], v[136:137], s[34:35]
    v_pk_add_f32 v[132:133], v[132:133], v[136:137]
    v_pk_fma_f32 v[134:135], v[136:137], v[136:137], v[134:135]
    v_lshlrev_b32 v138, 16, v75
    v_and_b32 v139, 0xffff0000, v75
    v_pk_add_f32 v[138:139], v[138:139], s[34:35]
    v_pk_add_f32 v[132:133], v[132:133], v[138:139]
    v_pk_fma_f32 v[134:135], v[138:139], v[138:139], v[134:135]
    s_waitcnt vmcnt(13)
    v_lshlrev_b32 v136, 16, v76
    v_and_b32 v137, 0xffff0000, v76
    v_pk_add_f32 v[136:137], v[136:137], s[34:35]
    v_pk_add_f32 v[132:133], v[132:133], v[136:137]
    v_pk_fma_f32 v[134:135], v[136:137], v[136:137], v[134:135]
    v_lshlrev_b32 v138, 16, v77
    v_and_b32 v139, 0xffff0000, v77
    v_pk_add_f32 v[138:139], v[138:139], s[34:35]
    v_pk_add_f32 v[132:133], v[132:133], v[138:139]
    v_pk_fma_f32 v[134:135], v[138:139], v[138:139], v[134:135]
    v_lshlrev_b32 v136, 16, v78
    v_and_b32 v137, 0xffff0000, v78
    v_pk_add_f32 v[136:137], v[136:137], s[34:35]
    v_pk_add_f32 v[132:133], v[132:133], v[136:137]
    v_pk_fma_f32 v[134:135], v[136:137], v[136:137], v[134:135]
    v_lshlrev_b32 v138, 16, v79
    v_and_b32 v139, 0xffff0000, v79
    v_pk_add_f32 v[138:139], v[138:139], s[34:35]
    v_pk_add_f32 v[132:133], v[132:133], v[138:139]
    v_pk_fma_f32 v[134:135], v[138:139], v[138:139], v[134:135]
    s_waitcnt vmcnt(12)
    v_lshlrev_b32 v136, 16, v80
    v_and_b32 v137, 0xffff0000, v80
    v_pk_add_f32 v[136:137], v[136:137], s[34:35]
    v_pk_add_f32 v[132:133], v[132:133], v[136:137]
    v_pk_fma_f32 v[134:135], v[136:137], v[136:137], v[134:135]
    v_lshlrev_b32 v138, 16, v81
    v_and_b32 v139, 0xffff0000, v81
    v_pk_add_f32 v[138:139], v[138:139], s[34:35]
    v_pk_add_f32 v[132:133], v[132:133], v[138:139]
    v_pk_fma_f32 v[134:135], v[138:139], v[138:139], v[134:135]
    v_lshlrev_b32 v136, 16, v82
    v_and_b32 v137, 0xffff0000, v82
    v_pk_add_f32 v[136:137], v[136:137], s[34:35]
    v_pk_add_f32 v[132:133], v[132:133], v[136:137]
    v_pk_fma_f32 v[134:135], v[136:137], v[136:137], v[134:135]
    v_lshlrev_b32 v138, 16, v83
    v_and_b32 v139, 0xffff0000, v83
    v_pk_add_f32 v[138:139], v[138:139], s[34:35]
    v_pk_add_f32 v[132:133], v[132:133], v[138:139]
    v_pk_fma_f32 v[134:135], v[138:139], v[138:139], v[134:135]
    s_waitcnt vmcnt(11)
    v_lshlrev_b32 v136, 16, v84
    v_and_b32 v137, 0xffff0000, v84
    v_pk_add_f32 v[136:137], v[136:137], s[34:35]
    v_pk_add_f32 v[132:133], v[132:133], v[136:137]
    v_pk_fma_f32 v[134:135], v[136:137], v[136:137], v[134:135]
    v_lshlrev_b32 v138, 16, v85
    v_and_b32 v139, 0xffff0000, v85
    v_pk_add_f32 v[138:139], v[138:139], s[34:35]
    v_pk_add_f32 v[132:133], v[132:133], v[138:139]
    v_pk_fma_f32 v[134:135], v[138:139], v[138:139], v[134:135]
    v_lshlrev_b32 v136, 16, v86
    v_and_b32 v137, 0xffff0000, v86
    v_pk_add_f32 v[136:137], v[136:137], s[34:35]
    v_pk_add_f32 v[132:133], v[132:133], v[136:137]
    v_pk_fma_f32 v[134:135], v[136:137], v[136:137], v[134:135]
    v_lshlrev_b32 v138, 16, v87
    v_and_b32 v139, 0xffff0000, v87
    v_pk_add_f32 v[138:139], v[138:139], s[34:35]
    v_pk_add_f32 v[132:133], v[132:133], v[138:139]
    v_pk_fma_f32 v[134:135], v[138:139], v[138:139], v[134:135]
    s_waitcnt vmcnt(10)
    v_lshlrev_b32 v136, 16, v88
    v_and_b32 v137, 0xffff0000, v88
    v_pk_add_f32 v[136:137], v[136:137], s[34:35]
    v_pk_add_f32 v[132:133], v[132:133], v[136:137]
    v_pk_fma_f32 v[134:135], v[136:137], v[136:137], v[134:135]
    v_lshlrev_b32 v138, 16, v89
    v_and_b32 v139, 0xffff0000, v89
    v_pk_add_f32 v[138:139], v[138:139], s[34:35]
    v_pk_add_f32 v[132:133], v[132:133], v[138:139]
    v_pk_fma_f32 v[134:135], v[138:139], v[138:139], v[134:135]
    v_lshlrev_b32 v136, 16, v90
    v_and_b32 v137, 0xffff0000, v90
    v_pk_add_f32 v[136:137], v[136:137], s[34:35]
    v_pk_add_f32 v[132:133], v[132:133], v[136:137]
    v_pk_fma_f32 v[134:135], v[136:137], v[136:137], v[134:135]
    v_lshlrev_b32 v138, 16, v91
    v_and_b32 v139, 0xffff0000, v91
    v_pk_add_f32 v[138:139], v[138:139], s[34:35]
    v_pk_add_f32 v[132:133], v[132:133], v[138:139]
    v_pk_fma_f32 v[134:135], v[138:139], v[138:139], v[134:135]
    s_waitcnt vmcnt(9)
    v_lshlrev_b32 v136, 16, v92
    v_and_b32 v137, 0xffff0000, v92
    v_pk_add_f32 v[136:137], v[136:137], s[34:35]
    v_pk_add_f32 v[132:133], v[132:133], v[136:137]
    v_pk_fma_f32 v[134:135], v[136:137], v[136:137], v[134:135]
    v_lshlrev_b32 v138, 16, v93
    v_and_b32 v139, 0xffff0000, v93
    v_pk_add_f32 v[138:139], v[138:139], s[34:35]
    v_pk_add_f32 v[132:133], v[132:133], v[138:139]
    v_pk_fma_f32 v[134:135], v[138:139], v[138:139], v[134:135]
    v_lshlrev_b32 v136, 16, v94
    v_and_b32 v137, 0xffff0000, v94
    v_pk_add_f32 v[136:137], v[136:137], s[34:35]
    v_pk_add_f32 v[132:133], v[132:133], v[136:137]
    v_pk_fma_f32 v[134:135], v[136:137], v[136:137], v[134:135]
    v_lshlrev_b32 v138, 16, v95
    v_and_b32 v139, 0xffff0000, v95
    v_pk_add_f32 v[138:139], v[138:139], s[34:35]
    v_pk_add_f32 v[132:133], v[132:133], v[138:139]
    v_pk_fma_f32 v[134:135], v[138:139], v[138:139], v[134:135]
    s_waitcnt vmcnt(8)
    v_lshlrev_b32 v136, 16, v96
    v_and_b32 v137, 0xffff0000, v96
    v_pk_add_f32 v[136:137], v[136:137], s[34:35]
    v_pk_add_f32 v[132:133], v[132:133], v[136:137]
    v_pk_fma_f32 v[134:135], v[136:137], v[136:137], v[134:135]
    v_lshlrev_b32 v138, 16, v97
    v_and_b32 v139, 0xffff0000, v97
    v_pk_add_f32 v[138:139], v[138:139], s[34:35]
    v_pk_add_f32 v[132:133], v[132:133], v[138:139]
    v_pk_fma_f32 v[134:135], v[138:139], v[138:139], v[134:135]
    v_lshlrev_b32 v136, 16, v98
    v_and_b32 v137, 0xffff0000, v98
    v_pk_add_f32 v[136:137], v[136:137], s[34:35]
    v_pk_add_f32 v[132:133], v[132:133], v[136:137]
    v_pk_fma_f32 v[134:135], v[136:137], v[136:137], v[134:135]
    v_lshlrev_b32 v138, 16, v99
    v_and_b32 v139, 0xffff0000, v99
    v_pk_add_f32 v[138:139], v[138:139], s[34:35]
    v_pk_add_f32 v[132:133], v[132:133], v[138:139]
    v_pk_fma_f32 v[134:135], v[138:139], v[138:139], v[134:135]
    s_waitcnt vmcnt(7)
    v_lshlrev_b32 v136, 16, v100
    v_and_b32 v137, 0xffff0000, v100
    v_pk_add_f32 v[136:137], v[136:137], s[34:35]
    v_pk_add_f32 v[132:133], v[132:133], v[136:137]
    v_pk_fma_f32 v[134:135], v[136:137], v[136:137], v[134:135]
    v_lshlrev_b32 v138, 16, v101
    v_and_b32 v139, 0xffff0000, v101
    v_pk_add_f32 v[138:139], v[138:139], s[34:35]
    v_pk_add_f32 v[132:133], v[132:133], v[138:139]
    v_pk_fma_f32 v[134:135], v[138:139], v[138:139], v[134:135]
    v_lshlrev_b32 v136, 16, v102
    v_and_b32 v137, 0xffff0000, v102
    v_pk_add_f32 v[136:137], v[136:137], s[34:35]
    v_pk_add_f32 v[132:133], v[132:133], v[136:137]
    v_pk_fma_f32 v[134:135], v[136:137], v[136:137], v[134:135]
    v_lshlrev_b32 v138, 16, v103
    v_and_b32 v139, 0xffff0000, v103
    v_pk_add_f32 v[138:139], v[138:139], s[34:35]
    v_pk_add_f32 v[132:133], v[132:133], v[138:139]
    v_pk_fma_f32 v[134:135], v[138:139], v[138:139], v[134:135]
    s_waitcnt vmcnt(6)
    v_lshlrev_b32 v136, 16, v104
    v_and_b32 v137, 0xffff0000, v104
    v_pk_add_f32 v[136:137], v[136:137], s[34:35]
    v_pk_add_f32 v[132:133], v[132:133], v[136:137]
    v_pk_fma_f32 v[134:135], v[136:137], v[136:137], v[134:135]
    v_lshlrev_b32 v138, 16, v105
    v_and_b32 v139, 0xffff0000, v105
    v_pk_add_f32 v[138:139], v[138:139], s[34:35]
    v_pk_add_f32 v[132:133], v[132:133], v[138:139]
    v_pk_fma_f32 v[134:135], v[138:139], v[138:139], v[134:135]
    v_lshlrev_b32 v136, 16, v106
    v_and_b32 v137, 0xffff0000, v106
    v_pk_add_f32 v[136:137], v[136:137], s[34:35]
    v_pk_add_f32 v[132:133], v[132:133], v[136:137]
    v_pk_fma_f32 v[134:135], v[136:137], v[136:137], v[134:135]
    v_lshlrev_b32 v138, 16, v107
    v_and_b32 v139, 0xffff0000, v107
    v_pk_add_f32 v[138:139], v[138:139], s[34:35]
    v_pk_add_f32 v[132:133], v[132:133], v[138:139]
    v_pk_fma_f32 v[134:135], v[138:139], v[138:139], v[134:135]
    s_waitcnt vmcnt(5)
    v_lshlrev_b32 v136, 16, v108
    v_and_b32 v137, 0xffff0000, v108
    v_pk_add_f32 v[136:137], v[136:137], s[34:35]
    v_pk_add_f32 v[132:133], v[132:133], v[136:137]
    v_pk_fma_f32 v[134:135], v[136:137], v[136:137], v[134:135]
    v_lshlrev_b32 v138, 16, v109
    v_and_b32 v139, 0xffff0000, v109
    v_pk_add_f32 v[138:139], v[138:139], s[34:35]
    v_pk_add_f32 v[132:133], v[132:133], v[138:139]
    v_pk_fma_f32 v[134:135], v[138:139], v[138:139], v[134:135]
    v_lshlrev_b32 v136, 16, v110
    v_and_b32 v137, 0xffff0000, v110
    v_pk_add_f32 v[136:137], v[136:137], s[34:35]
    v_pk_add_f32 v[132:133], v[132:133], v[136:137]
    v_pk_fma_f32 v[134:135], v[136:137], v[136:137], v[134:135]
    v_lshlrev_b32 v138, 16, v111
    v_and_b32 v139, 0xffff0000, v111
    v_pk_add_f32 v[138:139], v[138:139], s[34:35]
    v_pk_add_f32 v[132:133], v[132:133], v[138:139]
    v_pk_fma_f32 v[134:135], v[138:139], v[138:139], v[134:135]
    s_waitcnt vmcnt(4)
    v_lshlrev_b32 v136, 16, v112
    v_and_b32 v137, 0xffff0000, v112
    v_pk_add_f32 v[136:137], v[136:137], s[34:35]
    v_pk_add_f32 v[132:133], v[132:133], v[136:137]
    v_pk_fma_f32 v[134:135], v[136:137], v[136:137], v[134:135]
    v_lshlrev_b32 v138, 16, v113
    v_and_b32 v139, 0xffff0000, v113
    v_pk_add_f32 v[138:139], v[138:139], s[34:35]
    v_pk_add_f32 v[132:133], v[132:133], v[138:139]
    v_pk_fma_f32 v[134:135], v[138:139], v[138:139], v[134:135]
    v_lshlrev_b32 v136, 16, v114
    v_and_b32 v137, 0xffff0000, v114
    v_pk_add_f32 v[136:137], v[136:137], s[34:35]
    v_pk_add_f32 v[132:133], v[132:133], v[136:137]
    v_pk_fma_f32 v[134:135], v[136:137], v[136:137], v[134:135]
    v_lshlrev_b32 v138, 16, v115
    v_and_b32 v139, 0xffff0000, v115
    v_pk_add_f32 v[138:139], v[138:139], s[34:35]
    v_pk_add_f32 v[132:133], v[132:133], v[138:139]
    v_pk_fma_f32 v[134:135], v[138:139], v[138:139], v[134:135]
    s_waitcnt vmcnt(3)
    v_lshlrev_b32 v136, 16, v116
    v_and_b32 v137, 0xffff0000, v116
    v_pk_add_f32 v[136:137], v[136:137], s[34:35]
    v_pk_add_f32 v[132:133], v[132:133], v[136:137]
    v_pk_fma_f32 v[134:135], v[136:137], v[136:137], v[134:135]
    v_lshlrev_b32 v138, 16, v117
    v_and_b32 v139, 0xffff0000, v117
    v_pk_add_f32 v[138:139], v[138:139], s[34:35]
    v_pk_add_f32 v[132:133], v[132:133], v[138:139]
    v_pk_fma_f32 v[134:135], v[138:139], v[138:139], v[134:135]
    v_lshlrev_b32 v136, 16, v118
    v_and_b32 v137, 0xffff0000, v118
    v_pk_add_f32 v[136:137], v[136:137], s[34:35]
    v_pk_add_f32 v[132:133], v[132:133], v[136:137]
    v_pk_fma_f32 v[134:135], v[136:137], v[136:137], v[134:135]
    v_lshlrev_b32 v138, 16, v119
    v_and_b32 v139, 0xffff0000, v119
    v_pk_add_f32 v[138:139], v[138:139], s[34:35]
    v_pk_add_f32 v[132:133], v[132:133], v[138:139]
    v_pk_fma_f32 v[134:135], v[138:139], v[138:139], v[134:135]
    s_waitcnt vmcnt(2)
    v_lshlrev_b32 v136, 16, v120
    v_and_b32 v137, 0xffff0000, v120
    v_pk_add_f32 v[136:137], v[136:137], s[34:35]
    v_pk_add_f32 v[132:133], v[132:133], v[136:137]
    v_pk_fma_f32 v[134:135], v[136:137], v[136:137], v[134:135]
    v_lshlrev_b32 v138, 16, v121
    v_and_b32 v139, 0xffff0000, v121
    v_pk_add_f32 v[138:139], v[138:139], s[34:35]
    v_pk_add_f32 v[132:133], v[132:133], v[138:139]
    v_pk_fma_f32 v[134:135], v[138:139], v[138:139], v[134:135]
    v_lshlrev_b32 v136, 16, v122
    v_and_b32 v137, 0xffff0000, v122
    v_pk_add_f32 v[136:137], v[136:137], s[34:35]
    v_pk_add_f32 v[132:133], v[132:133], v[136:137]
    v_pk_fma_f32 v[134:135], v[136:137], v[136:137], v[134:135]
    v_lshlrev_b32 v138, 16, v123
    v_and_b32 v139, 0xffff0000, v123
    v_pk_add_f32 v[138:139], v[138:139], s[34:35]
    v_pk_add_f32 v[132:133], v[132:133], v[138:139]
    v_pk_fma_f32 v[134:135], v[138:139], v[138:139], v[134:135]
    s_waitcnt vmcnt(1)
    v_lshlrev_b32 v136, 16, v124
    v_and_b32 v137, 0xffff0000, v124
    v_pk_add_f32 v[136:137], v[136:137], s[34:35]
    v_pk_add_f32 v[132:133], v[132:133], v[136:137]
    v_pk_fma_f32 v[134:135], v[136:137], v[136:137], v[134:135]
    v_lshlrev_b32 v138, 16, v125
    v_and_b32 v139, 0xffff0000, v125
    v_pk_add_f32 v[138:139], v[138:139], s[34:35]
    v_pk_add_f32 v[132:133], v[132:133], v[138:139]
    v_pk_fma_f32 v[134:135], v[138:139], v[138:139], v[134:135]
    v_lshlrev_b32 v136, 16, v126
    v_and_b32 v137, 0xffff0000, v126
    v_pk_add_f32 v[136:137], v[136:137], s[34:35]
    v_pk_add_f32 v[132:133], v[132:133], v[136:137]
    v_pk_fma_f32 v[134:135], v[136:137], v[136:137], v[134:135]
    v_lshlrev_b32 v138, 16, v127
    v_and_b32 v139, 0xffff0000, v127
    v_pk_add_f32 v[138:139], v[138:139], s[34:35]
    v_pk_add_f32 v[132:133], v[132:133], v[138:139]
    v_pk_fma_f32 v[134:135], v[138:139], v[138:139], v[134:135]
    s_waitcnt vmcnt(0)
    v_lshlrev_b32 v136, 16, v128
    v_and_b32 v137, 0xffff0000, v128
    v_pk_add_f32 v[136:137], v[136:137], s[34:35]
    v_pk_add_f32 v[132:133], v[132:133], v[136:137]
    v_pk_fma_f32 v[134:135], v[136:137], v[136:137], v[134:135]
    v_lshlrev_b32 v138, 16, v129
    v_and_b32 v139, 0xffff0000, v129
    v_pk_add_f32 v[138:139], v[138:139], s[34:35]
    v_pk_add_f32 v[132:133], v[132:133], v[138:139]
    v_pk_fma_f32 v[134:135], v[138:139], v[138:139], v[134:135]
    v_lshlrev_b32 v136, 16, v130
    v_and_b32 v137, 0xffff0000, v130
    v_pk_add_f32 v[136:137], v[136:137], s[34:35]
    v_pk_add_f32 v[132:133], v[132:133], v[136:137]
    v_pk_fma_f32 v[134:135], v[136:137], v[136:137], v[134:135]
    v_lshlrev_b32 v138, 16, v131
    v_and_b32 v139, 0xffff0000, v131
    v_pk_add_f32 v[138:139], v[138:139], s[34:35]
    v_pk_add_f32 v[132:133], v[132:133], v[138:139]
    v_pk_fma_f32 v[134:135], v[138:139], v[138:139], v[134:135]
    v_add_f32 v132, v132, v133
    v_add_f32 v134, v134, v135
    v_mov_b32 v133, v134
    s_nop 0
    v_add_f32_dpp v132, v132, v132 row_shr:1 row_mask:0xf bank_mask:0xf
    v_add_f32_dpp v133, v133, v133 row_shr:1 row_mask:0xf bank_mask:0xf
    s_nop 0
    v_add_f32_dpp v132, v132, v132 row_shr:2 row_mask:0xf bank_mask:0xf
    v_add_f32_dpp v133, v133, v133 row_shr:2 row_mask:0xf bank_mask:0xf
    s_nop 0
    v_add_f32_dpp v132, v132, v132 row_shr:4 row_mask:0xf bank_mask:0xf
    v_add_f32_dpp v133, v133, v133 row_shr:4 row_mask:0xf bank_mask:0xf
    s_nop 0
    v_add_f32_dpp v132, v132, v132 row_shr:8 row_mask:0xf bank_mask:0xf
    v_add_f32_dpp v133, v133, v133 row_shr:8 row_mask:0xf bank_mask:0xf
    s_nop 0
    v_add_f32_dpp v132, v132, v132 row_bcast:15 row_mask:0xa bank_mask:0xf
    v_add_f32_dpp v133, v133, v133 row_bcast:15 row_mask:0xa bank_mask:0xf
    s_nop 0
    v_add_f32_dpp v132, v132, v132 row_bcast:31 row_mask:0xc bank_mask:0xf
    v_add_f32_dpp v133, v133, v133 row_bcast:31 row_mask:0xc bank_mask:0xf
    s_nop 0
    s_mov_b32 exec_lo, 0
    s_mov_b32 exec_hi, 0x80000000
    ds_write_b64 v2, v[132:133]
    s_mov_b64 exec, -1
    s_waitcnt lgkmcnt(0)
    s_barrier
    ds_read_b128 v[144:147], v3 offset:0
    s_waitcnt lgkmcnt(0)
    v_add_f32 v132, v144, v146
    v_add_f32 v134, v145, v147
    v_mul_f32 v136, 0x38000000, v132
    v_mul_f32 v137, v136, v136
    v_mov_b32 v139, 0x38000000
    v_fma_f32 v138, v134, v139, -v137
    v_max_f32 v138, 0, v138
    v_add_f32 v138, 0x3727c5ac, v138
    v_rsq_f32 v138, v138
    v_add_f32 v136, s32, v136
    v_mul_f32 v140, s26, v138
    v_mov_b32 v142, s28
    v_mov_b32 v141, v140
    v_fma_f32 v142, -v136, v140, v142
    v_mov_b32 v143, v142
    v_lshlrev_b32 v136, 16, v4
    v_and_b32 v137, 0xffff0000, v4
    v_pk_fma_f32 v[136:137], v[136:137], v[140:141], v[142:143]
    v_cvt_pk_bf16_f32 v4, v136, v137
    v_lshlrev_b32 v138, 16, v5
    v_and_b32 v139, 0xffff0000, v5
    v_pk_fma_f32 v[138:139], v[138:139], v[140:141], v[142:143]
    v_cvt_pk_bf16_f32 v5, v138, v139
    v_lshlrev_b32 v136, 16, v6
    v_and_b32 v137, 0xffff0000, v6
    v_pk_fma_f32 v[136:137], v[136:137], v[140:141], v[142:143]
    v_cvt_pk_bf16_f32 v6, v136, v137
    v_lshlrev_b32 v138, 16, v7
    v_and_b32 v139, 0xffff0000, v7
    v_pk_fma_f32 v[138:139], v[138:139], v[140:141], v[142:143]
    v_cvt_pk_bf16_f32 v7, v138, v139
    buffer_store_dwordx4 v[4:7], v1, s[16:19], s40 offen offset:0
    v_lshlrev_b32 v136, 16, v8
    v_and_b32 v137, 0xffff0000, v8
    v_pk_fma_f32 v[136:137], v[136:137], v[140:141], v[142:143]
    v_cvt_pk_bf16_f32 v8, v136, v137
    v_lshlrev_b32 v138, 16, v9
    v_and_b32 v139, 0xffff0000, v9
    v_pk_fma_f32 v[138:139], v[138:139], v[140:141], v[142:143]
    v_cvt_pk_bf16_f32 v9, v138, v139
    v_lshlrev_b32 v136, 16, v10
    v_and_b32 v137, 0xffff0000, v10
    v_pk_fma_f32 v[136:137], v[136:137], v[140:141], v[142:143]
    v_cvt_pk_bf16_f32 v10, v136, v137
    v_lshlrev_b32 v138, 16, v11
    v_and_b32 v139, 0xffff0000, v11
    v_pk_fma_f32 v[138:139], v[138:139], v[140:141], v[142:143]
    v_cvt_pk_bf16_f32 v11, v138, v139
    buffer_store_dwordx4 v[8:11], v1, s[16:19], s40 offen offset:2048
    v_lshlrev_b32 v136, 16, v12
    v_and_b32 v137, 0xffff0000, v12
    v_pk_fma_f32 v[136:137], v[136:137], v[140:141], v[142:143]
    v_cvt_pk_bf16_f32 v12, v136, v137
    v_lshlrev_b32 v138, 16, v13
    v_and_b32 v139, 0xffff0000, v13
    v_pk_fma_f32 v[138:139], v[138:139], v[140:141], v[142:143]
    v_cvt_pk_bf16_f32 v13, v138, v139
    v_lshlrev_b32 v136, 16, v14
    v_and_b32 v137, 0xffff0000, v14
    v_pk_fma_f32 v[136:137], v[136:137], v[140:141], v[142:143]
    v_cvt_pk_bf16_f32 v14, v136, v137
    v_lshlrev_b32 v138, 16, v15
    v_and_b32 v139, 0xffff0000, v15
    v_pk_fma_f32 v[138:139], v[138:139], v[140:141], v[142:143]
    v_cvt_pk_bf16_f32 v15, v138, v139
    buffer_store_dwordx4 v[12:15], v1, s[16:19], s41 offen offset:0
    v_lshlrev_b32 v136, 16, v16
    v_and_b32 v137, 0xffff0000, v16
    v_pk_fma_f32 v[136:137], v[136:137], v[140:141], v[142:143]
    v_cvt_pk_bf16_f32 v16, v136, v137
    v_lshlrev_b32 v138, 16, v17
    v_and_b32 v139, 0xffff0000, v17
    v_pk_fma_f32 v[138:139], v[138:139], v[140:141], v[142:143]
    v_cvt_pk_bf16_f32 v17, v138, v139
    v_lshlrev_b32 v136, 16, v18
    v_and_b32 v137, 0xffff0000, v18
    v_pk_fma_f32 v[136:137], v[136:137], v[140:141], v[142:143]
    v_cvt_pk_bf16_f32 v18, v136, v137
    v_lshlrev_b32 v138, 16, v19
    v_and_b32 v139, 0xffff0000, v19
    v_pk_fma_f32 v[138:139], v[138:139], v[140:141], v[142:143]
    v_cvt_pk_bf16_f32 v19, v138, v139
    buffer_store_dwordx4 v[16:19], v1, s[16:19], s41 offen offset:2048
    v_lshlrev_b32 v136, 16, v20
    v_and_b32 v137, 0xffff0000, v20
    v_pk_fma_f32 v[136:137], v[136:137], v[140:141], v[142:143]
    v_cvt_pk_bf16_f32 v20, v136, v137
    v_lshlrev_b32 v138, 16, v21
    v_and_b32 v139, 0xffff0000, v21
    v_pk_fma_f32 v[138:139], v[138:139], v[140:141], v[142:143]
    v_cvt_pk_bf16_f32 v21, v138, v139
    v_lshlrev_b32 v136, 16, v22
    v_and_b32 v137, 0xffff0000, v22
    v_pk_fma_f32 v[136:137], v[136:137], v[140:141], v[142:143]
    v_cvt_pk_bf16_f32 v22, v136, v137
    v_lshlrev_b32 v138, 16, v23
    v_and_b32 v139, 0xffff0000, v23
    v_pk_fma_f32 v[138:139], v[138:139], v[140:141], v[142:143]
    v_cvt_pk_bf16_f32 v23, v138, v139
    buffer_store_dwordx4 v[20:23], v1, s[16:19], s42 offen offset:0
    v_lshlrev_b32 v136, 16, v24
    v_and_b32 v137, 0xffff0000, v24
    v_pk_fma_f32 v[136:137], v[136:137], v[140:141], v[142:143]
    v_cvt_pk_bf16_f32 v24, v136, v137
    v_lshlrev_b32 v138, 16, v25
    v_and_b32 v139, 0xffff0000, v25
    v_pk_fma_f32 v[138:139], v[138:139], v[140:141], v[142:143]
    v_cvt_pk_bf16_f32 v25, v138, v139
    v_lshlrev_b32 v136, 16, v26
    v_and_b32 v137, 0xffff0000, v26
    v_pk_fma_f32 v[136:137], v[136:137], v[140:141], v[142:143]
    v_cvt_pk_bf16_f32 v26, v136, v137
    v_lshlrev_b32 v138, 16, v27
    v_and_b32 v139, 0xffff0000, v27
    v_pk_fma_f32 v[138:139], v[138:139], v[140:141], v[142:143]
    v_cvt_pk_bf16_f32 v27, v138, v139
    buffer_store_dwordx4 v[24:27], v1, s[16:19], s42 offen offset:2048
    v_lshlrev_b32 v136, 16, v28
    v_and_b32 v137, 0xffff0000, v28
    v_pk_fma_f32 v[136:137], v[136:137], v[140:141], v[142:143]
    v_cvt_pk_bf16_f32 v28, v136, v137
    v_lshlrev_b32 v138, 16, v29
    v_and_b32 v139, 0xffff0000, v29
    v_pk_fma_f32 v[138:139], v[138:139], v[140:141], v[142:143]
    v_cvt_pk_bf16_f32 v29, v138, v139
    v_lshlrev_b32 v136, 16, v30
    v_and_b32 v137, 0xffff0000, v30
    v_pk_fma_f32 v[136:137], v[136:137], v[140:141], v[142:143]
    v_cvt_pk_bf16_f32 v30, v136, v137
    v_lshlrev_b32 v138, 16, v31
    v_and_b32 v139, 0xffff0000, v31
    v_pk_fma_f32 v[138:139], v[138:139], v[140:141], v[142:143]
    v_cvt_pk_bf16_f32 v31, v138, v139
    buffer_store_dwordx4 v[28:31], v1, s[16:19], s43 offen offset:0
    v_lshlrev_b32 v136, 16, v32
    v_and_b32 v137, 0xffff0000, v32
    v_pk_fma_f32 v[136:137], v[136:137], v[140:141], v[142:143]
    v_cvt_pk_bf16_f32 v32, v136, v137
    v_lshlrev_b32 v138, 16, v33
    v_and_b32 v139, 0xffff0000, v33
    v_pk_fma_f32 v[138:139], v[138:139], v[140:141], v[142:143]
    v_cvt_pk_bf16_f32 v33, v138, v139
    v_lshlrev_b32 v136, 16, v34
    v_and_b32 v137, 0xffff0000, v34
    v_pk_fma_f32 v[136:137], v[136:137], v[140:141], v[142:143]
    v_cvt_pk_bf16_f32 v34, v136, v137
    v_lshlrev_b32 v138, 16, v35
    v_and_b32 v139, 0xffff0000, v35
    v_pk_fma_f32 v[138:139], v[138:139], v[140:141], v[142:143]
    v_cvt_pk_bf16_f32 v35, v138, v139
    buffer_store_dwordx4 v[32:35], v1, s[16:19], s43 offen offset:2048
    v_lshlrev_b32 v136, 16, v36
    v_and_b32 v137, 0xffff0000, v36
    v_pk_fma_f32 v[136:137], v[136:137], v[140:141], v[142:143]
    v_cvt_pk_bf16_f32 v36, v136, v137
    v_lshlrev_b32 v138, 16, v37
    v_and_b32 v139, 0xffff0000, v37
    v_pk_fma_f32 v[138:139], v[138:139], v[140:141], v[142:143]
    v_cvt_pk_bf16_f32 v37, v138, v139
    v_lshlrev_b32 v136, 16, v38
    v_and_b32 v137, 0xffff0000, v38
    v_pk_fma_f32 v[136:137], v[136:137], v[140:141], v[142:143]
    v_cvt_pk_bf16_f32 v38, v136, v137
    v_lshlrev_b32 v138, 16, v39
    v_and_b32 v139, 0xffff0000, v39
    v_pk_fma_f32 v[138:139], v[138:139], v[140:141], v[142:143]
    v_cvt_pk_bf16_f32 v39, v138, v139
    buffer_store_dwordx4 v[36:39], v1, s[16:19], s44 offen offset:0
    v_lshlrev_b32 v136, 16, v40
    v_and_b32 v137, 0xffff0000, v40
    v_pk_fma_f32 v[136:137], v[136:137], v[140:141], v[142:143]
    v_cvt_pk_bf16_f32 v40, v136, v137
    v_lshlrev_b32 v138, 16, v41
    v_and_b32 v139, 0xffff0000, v41
    v_pk_fma_f32 v[138:139], v[138:139], v[140:141], v[142:143]
    v_cvt_pk_bf16_f32 v41, v138, v139
    v_lshlrev_b32 v136, 16, v42
    v_and_b32 v137, 0xffff0000, v42
    v_pk_fma_f32 v[136:137], v[136:137], v[140:141], v[142:143]
    v_cvt_pk_bf16_f32 v42, v136, v137
    v_lshlrev_b32 v138, 16, v43
    v_and_b32 v139, 0xffff0000, v43
    v_pk_fma_f32 v[138:139], v[138:139], v[140:141], v[142:143]
    v_cvt_pk_bf16_f32 v43, v138, v139
    buffer_store_dwordx4 v[40:43], v1, s[16:19], s44 offen offset:2048
    v_lshlrev_b32 v136, 16, v44
    v_and_b32 v137, 0xffff0000, v44
    v_pk_fma_f32 v[136:137], v[136:137], v[140:141], v[142:143]
    v_cvt_pk_bf16_f32 v44, v136, v137
    v_lshlrev_b32 v138, 16, v45
    v_and_b32 v139, 0xffff0000, v45
    v_pk_fma_f32 v[138:139], v[138:139], v[140:141], v[142:143]
    v_cvt_pk_bf16_f32 v45, v138, v139
    v_lshlrev_b32 v136, 16, v46
    v_and_b32 v137, 0xffff0000, v46
    v_pk_fma_f32 v[136:137], v[136:137], v[140:141], v[142:143]
    v_cvt_pk_bf16_f32 v46, v136, v137
    v_lshlrev_b32 v138, 16, v47
    v_and_b32 v139, 0xffff0000, v47
    v_pk_fma_f32 v[138:139], v[138:139], v[140:141], v[142:143]
    v_cvt_pk_bf16_f32 v47, v138, v139
    buffer_store_dwordx4 v[44:47], v1, s[16:19], s45 offen offset:0
    v_lshlrev_b32 v136, 16, v48
    v_and_b32 v137, 0xffff0000, v48
    v_pk_fma_f32 v[136:137], v[136:137], v[140:141], v[142:143]
    v_cvt_pk_bf16_f32 v48, v136, v137
    v_lshlrev_b32 v138, 16, v49
    v_and_b32 v139, 0xffff0000, v49
    v_pk_fma_f32 v[138:139], v[138:139], v[140:141], v[142:143]
    v_cvt_pk_bf16_f32 v49, v138, v139
    v_lshlrev_b32 v136, 16, v50
    v_and_b32 v137, 0xffff0000, v50
    v_pk_fma_f32 v[136:137], v[136:137], v[140:141], v[142:143]
    v_cvt_pk_bf16_f32 v50, v136, v137
    v_lshlrev_b32 v138, 16, v51
    v_and_b32 v139, 0xffff0000, v51
    v_pk_fma_f32 v[138:139], v[138:139], v[140:141], v[142:143]
    v_cvt_pk_bf16_f32 v51, v138, v139
    buffer_store_dwordx4 v[48:51], v1, s[16:19], s45 offen offset:2048
    v_lshlrev_b32 v136, 16, v52
    v_and_b32 v137, 0xffff0000, v52
    v_pk_fma_f32 v[136:137], v[136:137], v[140:141], v[142:143]
    v_cvt_pk_bf16_f32 v52, v136, v137
    v_lshlrev_b32 v138, 16, v53
    v_and_b32 v139, 0xffff0000, v53
    v_pk_fma_f32 v[138:139], v[138:139], v[140:141], v[142:143]
    v_cvt_pk_bf16_f32 v53, v138, v139
    v_lshlrev_b32 v136, 16, v54
    v_and_b32 v137, 0xffff0000, v54
    v_pk_fma_f32 v[136:137], v[136:137], v[140:141], v[142:143]
    v_cvt_pk_bf16_f32 v54, v136, v137
    v_lshlrev_b32 v138, 16, v55
    v_and_b32 v139, 0xffff0000, v55
    v_pk_fma_f32 v[138:139], v[138:139], v[140:141], v[142:143]
    v_cvt_pk_bf16_f32 v55, v138, v139
    buffer_store_dwordx4 v[52:55], v1, s[16:19], s46 offen offset:0
    v_lshlrev_b32 v136, 16, v56
    v_and_b32 v137, 0xffff0000, v56
    v_pk_fma_f32 v[136:137], v[136:137], v[140:141], v[142:143]
    v_cvt_pk_bf16_f32 v56, v136, v137
    v_lshlrev_b32 v138, 16, v57
    v_and_b32 v139, 0xffff0000, v57
    v_pk_fma_f32 v[138:139], v[138:139], v[140:141], v[142:143]
    v_cvt_pk_bf16_f32 v57, v138, v139
    v_lshlrev_b32 v136, 16, v58
    v_and_b32 v137, 0xffff0000, v58
    v_pk_fma_f32 v[136:137], v[136:137], v[140:141], v[142:143]
    v_cvt_pk_bf16_f32 v58, v136, v137
    v_lshlrev_b32 v138, 16, v59
    v_and_b32 v139, 0xffff0000, v59
    v_pk_fma_f32 v[138:139], v[138:139], v[140:141], v[142:143]
    v_cvt_pk_bf16_f32 v59, v138, v139
    buffer_store_dwordx4 v[56:59], v1, s[16:19], s46 offen offset:2048
    v_lshlrev_b32 v136, 16, v60
    v_and_b32 v137, 0xffff0000, v60
    v_pk_fma_f32 v[136:137], v[136:137], v[140:141], v[142:143]
    v_cvt_pk_bf16_f32 v60, v136, v137
    v_lshlrev_b32 v138, 16, v61
    v_and_b32 v139, 0xffff0000, v61
    v_pk_fma_f32 v[138:139], v[138:139], v[140:141], v[142:143]
    v_cvt_pk_bf16_f32 v61, v138, v139
    v_lshlrev_b32 v136, 16, v62
    v_and_b32 v137, 0xffff0000, v62
    v_pk_fma_f32 v[136:137], v[136:137], v[140:141], v[142:143]
    v_cvt_pk_bf16_f32 v62, v136, v137
    v_lshlrev_b32 v138, 16, v63
    v_and_b32 v139, 0xffff0000, v63
    v_pk_fma_f32 v[138:139], v[138:139], v[140:141], v[142:143]
    v_cvt_pk_bf16_f32 v63, v138, v139
    buffer_store_dwordx4 v[60:63], v1, s[16:19], s47 offen offset:0
    v_lshlrev_b32 v136, 16, v64
    v_and_b32 v137, 0xffff0000, v64
    v_pk_fma_f32 v[136:137], v[136:137], v[140:141], v[142:143]
    v_cvt_pk_bf16_f32 v64, v136, v137
    v_lshlrev_b32 v138, 16, v65
    v_and_b32 v139, 0xffff0000, v65
    v_pk_fma_f32 v[138:139], v[138:139], v[140:141], v[142:143]
    v_cvt_pk_bf16_f32 v65, v138, v139
    v_lshlrev_b32 v136, 16, v66
    v_and_b32 v137, 0xffff0000, v66
    v_pk_fma_f32 v[136:137], v[136:137], v[140:141], v[142:143]
    v_cvt_pk_bf16_f32 v66, v136, v137
    v_lshlrev_b32 v138, 16, v67
    v_and_b32 v139, 0xffff0000, v67
    v_pk_fma_f32 v[138:139], v[138:139], v[140:141], v[142:143]
    v_cvt_pk_bf16_f32 v67, v138, v139
    buffer_store_dwordx4 v[64:67], v1, s[16:19], s47 offen offset:2048
    v_lshlrev_b32 v136, 16, v68
    v_and_b32 v137, 0xffff0000, v68
    v_pk_fma_f32 v[136:137], v[136:137], v[140:141], v[142:143]
    v_cvt_pk_bf16_f32 v68, v136, v137
    v_lshlrev_b32 v138, 16, v69
    v_and_b32 v139, 0xffff0000, v69
    v_pk_fma_f32 v[138:139], v[138:139], v[140:141], v[142:143]
    v_cvt_pk_bf16_f32 v69, v138, v139
    v_lshlrev_b32 v136, 16, v70
    v_and_b32 v137, 0xffff0000, v70
    v_pk_fma_f32 v[136:137], v[136:137], v[140:141], v[142:143]
    v_cvt_pk_bf16_f32 v70, v136, v137
    v_lshlrev_b32 v138, 16, v71
    v_and_b32 v139, 0xffff0000, v71
    v_pk_fma_f32 v[138:139], v[138:139], v[140:141], v[142:143]
    v_cvt_pk_bf16_f32 v71, v138, v139
    buffer_store_dwordx4 v[68:71], v1, s[16:19], s48 offen offset:0
    v_lshlrev_b32 v136, 16, v72
    v_and_b32 v137, 0xffff0000, v72
    v_pk_fma_f32 v[136:137], v[136:137], v[140:141], v[142:143]
    v_cvt_pk_bf16_f32 v72, v136, v137
    v_lshlrev_b32 v138, 16, v73
    v_and_b32 v139, 0xffff0000, v73
    v_pk_fma_f32 v[138:139], v[138:139], v[140:141], v[142:143]
    v_cvt_pk_bf16_f32 v73, v138, v139
    v_lshlrev_b32 v136, 16, v74
    v_and_b32 v137, 0xffff0000, v74
    v_pk_fma_f32 v[136:137], v[136:137], v[140:141], v[142:143]
    v_cvt_pk_bf16_f32 v74, v136, v137
    v_lshlrev_b32 v138, 16, v75
    v_and_b32 v139, 0xffff0000, v75
    v_pk_fma_f32 v[138:139], v[138:139], v[140:141], v[142:143]
    v_cvt_pk_bf16_f32 v75, v138, v139
    buffer_store_dwordx4 v[72:75], v1, s[16:19], s48 offen offset:2048
    v_lshlrev_b32 v136, 16, v76
    v_and_b32 v137, 0xffff0000, v76
    v_pk_fma_f32 v[136:137], v[136:137], v[140:141], v[142:143]
    v_cvt_pk_bf16_f32 v76, v136, v137
    v_lshlrev_b32 v138, 16, v77
    v_and_b32 v139, 0xffff0000, v77
    v_pk_fma_f32 v[138:139], v[138:139], v[140:141], v[142:143]
    v_cvt_pk_bf16_f32 v77, v138, v139
    v_lshlrev_b32 v136, 16, v78
    v_and_b32 v137, 0xffff0000, v78
    v_pk_fma_f32 v[136:137], v[136:137], v[140:141], v[142:143]
    v_cvt_pk_bf16_f32 v78, v136, v137
    v_lshlrev_b32 v138, 16, v79
    v_and_b32 v139, 0xffff0000, v79
    v_pk_fma_f32 v[138:139], v[138:139], v[140:141], v[142:143]
    v_cvt_pk_bf16_f32 v79, v138, v139
    buffer_store_dwordx4 v[76:79], v1, s[16:19], s49 offen offset:0
    v_lshlrev_b32 v136, 16, v80
    v_and_b32 v137, 0xffff0000, v80
    v_pk_fma_f32 v[136:137], v[136:137], v[140:141], v[142:143]
    v_cvt_pk_bf16_f32 v80, v136, v137
    v_lshlrev_b32 v138, 16, v81
    v_and_b32 v139, 0xffff0000, v81
    v_pk_fma_f32 v[138:139], v[138:139], v[140:141], v[142:143]
    v_cvt_pk_bf16_f32 v81, v138, v139
    v_lshlrev_b32 v136, 16, v82
    v_and_b32 v137, 0xffff0000, v82
    v_pk_fma_f32 v[136:137], v[136:137], v[140:141], v[142:143]
    v_cvt_pk_bf16_f32 v82, v136, v137
    v_lshlrev_b32 v138, 16, v83
    v_and_b32 v139, 0xffff0000, v83
    v_pk_fma_f32 v[138:139], v[138:139], v[140:141], v[142:143]
    v_cvt_pk_bf16_f32 v83, v138, v139
    buffer_store_dwordx4 v[80:83], v1, s[16:19], s49 offen offset:2048
    v_lshlrev_b32 v136, 16, v84
    v_and_b32 v137, 0xffff0000, v84
    v_pk_fma_f32 v[136:137], v[136:137], v[140:141], v[142:143]
    v_cvt_pk_bf16_f32 v84, v136, v137
    v_lshlrev_b32 v138, 16, v85
    v_and_b32 v139, 0xffff0000, v85
    v_pk_fma_f32 v[138:139], v[138:139], v[140:141], v[142:143]
    v_cvt_pk_bf16_f32 v85, v138, v139
    v_lshlrev_b32 v136, 16, v86
    v_and_b32 v137, 0xffff0000, v86
    v_pk_fma_f32 v[136:137], v[136:137], v[140:141], v[142:143]
    v_cvt_pk_bf16_f32 v86, v136, v137
    v_lshlrev_b32 v138, 16, v87
    v_and_b32 v139, 0xffff0000, v87
    v_pk_fma_f32 v[138:139], v[138:139], v[140:141], v[142:143]
    v_cvt_pk_bf16_f32 v87, v138, v139
    buffer_store_dwordx4 v[84:87], v1, s[16:19], s50 offen offset:0
    v_lshlrev_b32 v136, 16, v88
    v_and_b32 v137, 0xffff0000, v88
    v_pk_fma_f32 v[136:137], v[136:137], v[140:141], v[142:143]
    v_cvt_pk_bf16_f32 v88, v136, v137
    v_lshlrev_b32 v138, 16, v89
    v_and_b32 v139, 0xffff0000, v89
    v_pk_fma_f32 v[138:139], v[138:139], v[140:141], v[142:143]
    v_cvt_pk_bf16_f32 v89, v138, v139
    v_lshlrev_b32 v136, 16, v90
    v_and_b32 v137, 0xffff0000, v90
    v_pk_fma_f32 v[136:137], v[136:137], v[140:141], v[142:143]
    v_cvt_pk_bf16_f32 v90, v136, v137
    v_lshlrev_b32 v138, 16, v91
    v_and_b32 v139, 0xffff0000, v91
    v_pk_fma_f32 v[138:139], v[138:139], v[140:141], v[142:143]
    v_cvt_pk_bf16_f32 v91, v138, v139
    buffer_store_dwordx4 v[88:91], v1, s[16:19], s50 offen offset:2048
    v_lshlrev_b32 v136, 16, v92
    v_and_b32 v137, 0xffff0000, v92
    v_pk_fma_f32 v[136:137], v[136:137], v[140:141], v[142:143]
    v_cvt_pk_bf16_f32 v92, v136, v137
    v_lshlrev_b32 v138, 16, v93
    v_and_b32 v139, 0xffff0000, v93
    v_pk_fma_f32 v[138:139], v[138:139], v[140:141], v[142:143]
    v_cvt_pk_bf16_f32 v93, v138, v139
    v_lshlrev_b32 v136, 16, v94
    v_and_b32 v137, 0xffff0000, v94
    v_pk_fma_f32 v[136:137], v[136:137], v[140:141], v[142:143]
    v_cvt_pk_bf16_f32 v94, v136, v137
    v_lshlrev_b32 v138, 16, v95
    v_and_b32 v139, 0xffff0000, v95
    v_pk_fma_f32 v[138:139], v[138:139], v[140:141], v[142:143]
    v_cvt_pk_bf16_f32 v95, v138, v139
    buffer_store_dwordx4 v[92:95], v1, s[16:19], s51 offen offset:0
    v_lshlrev_b32 v136, 16, v96
    v_and_b32 v137, 0xffff0000, v96
    v_pk_fma_f32 v[136:137], v[136:137], v[140:141], v[142:143]
    v_cvt_pk_bf16_f32 v96, v136, v137
    v_lshlrev_b32 v138, 16, v97
    v_and_b32 v139, 0xffff0000, v97
    v_pk_fma_f32 v[138:139], v[138:139], v[140:141], v[142:143]
    v_cvt_pk_bf16_f32 v97, v138, v139
    v_lshlrev_b32 v136, 16, v98
    v_and_b32 v137, 0xffff0000, v98
    v_pk_fma_f32 v[136:137], v[136:137], v[140:141], v[142:143]
    v_cvt_pk_bf16_f32 v98, v136, v137
    v_lshlrev_b32 v138, 16, v99
    v_and_b32 v139, 0xffff0000, v99
    v_pk_fma_f32 v[138:139], v[138:139], v[140:141], v[142:143]
    v_cvt_pk_bf16_f32 v99, v138, v139
    buffer_store_dwordx4 v[96:99], v1, s[16:19], s51 offen offset:2048
    v_lshlrev_b32 v136, 16, v100
    v_and_b32 v137, 0xffff0000, v100
    v_pk_fma_f32 v[136:137], v[136:137], v[140:141], v[142:143]
    v_cvt_pk_bf16_f32 v100, v136, v137
    v_lshlrev_b32 v138, 16, v101
    v_and_b32 v139, 0xffff0000, v101
    v_pk_fma_f32 v[138:139], v[138:139], v[140:141], v[142:143]
    v_cvt_pk_bf16_f32 v101, v138, v139
    v_lshlrev_b32 v136, 16, v102
    v_and_b32 v137, 0xffff0000, v102
    v_pk_fma_f32 v[136:137], v[136:137], v[140:141], v[142:143]
    v_cvt_pk_bf16_f32 v102, v136, v137
    v_lshlrev_b32 v138, 16, v103
    v_and_b32 v139, 0xffff0000, v103
    v_pk_fma_f32 v[138:139], v[138:139], v[140:141], v[142:143]
    v_cvt_pk_bf16_f32 v103, v138, v139
    buffer_store_dwordx4 v[100:103], v1, s[16:19], s52 offen offset:0
    v_lshlrev_b32 v136, 16, v104
    v_and_b32 v137, 0xffff0000, v104
    v_pk_fma_f32 v[136:137], v[136:137], v[140:141], v[142:143]
    v_cvt_pk_bf16_f32 v104, v136, v137
    v_lshlrev_b32 v138, 16, v105
    v_and_b32 v139, 0xffff0000, v105
    v_pk_fma_f32 v[138:139], v[138:139], v[140:141], v[142:143]
    v_cvt_pk_bf16_f32 v105, v138, v139
    v_lshlrev_b32 v136, 16, v106
    v_and_b32 v137, 0xffff0000, v106
    v_pk_fma_f32 v[136:137], v[136:137], v[140:141], v[142:143]
    v_cvt_pk_bf16_f32 v106, v136, v137
    v_lshlrev_b32 v138, 16, v107
    v_and_b32 v139, 0xffff0000, v107
    v_pk_fma_f32 v[138:139], v[138:139], v[140:141], v[142:143]
    v_cvt_pk_bf16_f32 v107, v138, v139
    buffer_store_dwordx4 v[104:107], v1, s[16:19], s52 offen offset:2048
    v_lshlrev_b32 v136, 16, v108
    v_and_b32 v137, 0xffff0000, v108
    v_pk_fma_f32 v[136:137], v[136:137], v[140:141], v[142:143]
    v_cvt_pk_bf16_f32 v108, v136, v137
    v_lshlrev_b32 v138, 16, v109
    v_and_b32 v139, 0xffff0000, v109
    v_pk_fma_f32 v[138:139], v[138:139], v[140:141], v[142:143]
    v_cvt_pk_bf16_f32 v109, v138, v139
    v_lshlrev_b32 v136, 16, v110
    v_and_b32 v137, 0xffff0000, v110
    v_pk_fma_f32 v[136:137], v[136:137], v[140:141], v[142:143]
    v_cvt_pk_bf16_f32 v110, v136, v137
    v_lshlrev_b32 v138, 16, v111
    v_and_b32 v139, 0xffff0000, v111
    v_pk_fma_f32 v[138:139], v[138:139], v[140:141], v[142:143]
    v_cvt_pk_bf16_f32 v111, v138, v139
    buffer_store_dwordx4 v[108:111], v1, s[16:19], s53 offen offset:0
    v_lshlrev_b32 v136, 16, v112
    v_and_b32 v137, 0xffff0000, v112
    v_pk_fma_f32 v[136:137], v[136:137], v[140:141], v[142:143]
    v_cvt_pk_bf16_f32 v112, v136, v137
    v_lshlrev_b32 v138, 16, v113
    v_and_b32 v139, 0xffff0000, v113
    v_pk_fma_f32 v[138:139], v[138:139], v[140:141], v[142:143]
    v_cvt_pk_bf16_f32 v113, v138, v139
    v_lshlrev_b32 v136, 16, v114
    v_and_b32 v137, 0xffff0000, v114
    v_pk_fma_f32 v[136:137], v[136:137], v[140:141], v[142:143]
    v_cvt_pk_bf16_f32 v114, v136, v137
    v_lshlrev_b32 v138, 16, v115
    v_and_b32 v139, 0xffff0000, v115
    v_pk_fma_f32 v[138:139], v[138:139], v[140:141], v[142:143]
    v_cvt_pk_bf16_f32 v115, v138, v139
    buffer_store_dwordx4 v[112:115], v1, s[16:19], s53 offen offset:2048
    v_lshlrev_b32 v136, 16, v116
    v_and_b32 v137, 0xffff0000, v116
    v_pk_fma_f32 v[136:137], v[136:137], v[140:141], v[142:143]
    v_cvt_pk_bf16_f32 v116, v136, v137
    v_lshlrev_b32 v138, 16, v117
    v_and_b32 v139, 0xffff0000, v117
    v_pk_fma_f32 v[138:139], v[138:139], v[140:141], v[142:143]
    v_cvt_pk_bf16_f32 v117, v138, v139
    v_lshlrev_b32 v136, 16, v118
    v_and_b32 v137, 0xffff0000, v118
    v_pk_fma_f32 v[136:137], v[136:137], v[140:141], v[142:143]
    v_cvt_pk_bf16_f32 v118, v136, v137
    v_lshlrev_b32 v138, 16, v119
    v_and_b32 v139, 0xffff0000, v119
    v_pk_fma_f32 v[138:139], v[138:139], v[140:141], v[142:143]
    v_cvt_pk_bf16_f32 v119, v138, v139
    buffer_store_dwordx4 v[116:119], v1, s[16:19], s54 offen offset:0
    v_lshlrev_b32 v136, 16, v120
    v_and_b32 v137, 0xffff0000, v120
    v_pk_fma_f32 v[136:137], v[136:137], v[140:141], v[142:143]
    v_cvt_pk_bf16_f32 v120, v136, v137
    v_lshlrev_b32 v138, 16, v121
    v_and_b32 v139, 0xffff0000, v121
    v_pk_fma_f32 v[138:139], v[138:139], v[140:141], v[142:143]
    v_cvt_pk_bf16_f32 v121, v138, v139
    v_lshlrev_b32 v136, 16, v122
    v_and_b32 v137, 0xffff0000, v122
    v_pk_fma_f32 v[136:137], v[136:137], v[140:141], v[142:143]
    v_cvt_pk_bf16_f32 v122, v136, v137
    v_lshlrev_b32 v138, 16, v123
    v_and_b32 v139, 0xffff0000, v123
    v_pk_fma_f32 v[138:139], v[138:139], v[140:141], v[142:143]
    v_cvt_pk_bf16_f32 v123, v138, v139
    buffer_store_dwordx4 v[120:123], v1, s[16:19], s54 offen offset:2048
    v_lshlrev_b32 v136, 16, v124
    v_and_b32 v137, 0xffff0000, v124
    v_pk_fma_f32 v[136:137], v[136:137], v[140:141], v[142:143]
    v_cvt_pk_bf16_f32 v124, v136, v137
    v_lshlrev_b32 v138, 16, v125
    v_and_b32 v139, 0xffff0000, v125
    v_pk_fma_f32 v[138:139], v[138:139], v[140:141], v[142:143]
    v_cvt_pk_bf16_f32 v125, v138, v139
    v_lshlrev_b32 v136, 16, v126
    v_and_b32 v137, 0xffff0000, v126
    v_pk_fma_f32 v[136:137], v[136:137], v[140:141], v[142:143]
    v_cvt_pk_bf16_f32 v126, v136, v137
    v_lshlrev_b32 v138, 16, v127
    v_and_b32 v139, 0xffff0000, v127
    v_pk_fma_f32 v[138:139], v[138:139], v[140:141], v[142:143]
    v_cvt_pk_bf16_f32 v127, v138, v139
    buffer_store_dwordx4 v[124:127], v1, s[16:19], s55 offen offset:0
    v_lshlrev_b32 v136, 16, v128
    v_and_b32 v137, 0xffff0000, v128
    v_pk_fma_f32 v[136:137], v[136:137], v[140:141], v[142:143]
    v_cvt_pk_bf16_f32 v128, v136, v137
    v_lshlrev_b32 v138, 16, v129
    v_and_b32 v139, 0xffff0000, v129
    v_pk_fma_f32 v[138:139], v[138:139], v[140:141], v[142:143]
    v_cvt_pk_bf16_f32 v129, v138, v139
    v_lshlrev_b32 v136, 16, v130
    v_and_b32 v137, 0xffff0000, v130
    v_pk_fma_f32 v[136:137], v[136:137], v[140:141], v[142:143]
    v_cvt_pk_bf16_f32 v130, v136, v137
    v_lshlrev_b32 v138, 16, v131
    v_and_b32 v139, 0xffff0000, v131
    v_pk_fma_f32 v[138:139], v[138:139], v[140:141], v[142:143]
    v_cvt_pk_bf16_f32 v131, v138, v139
    buffer_store_dwordx4 v[128:131], v1, s[16:19], s55 offen offset:2048
L_end:
    s_endpgm
.section .rodata,"a"
.p2align 6
.amdhsa_kernel standalone__instancenorm__prompt_kernel
  .amdhsa_next_free_vgpr 148
  .amdhsa_next_free_sgpr 56
  .amdhsa_accum_offset 148
  .amdhsa_group_segment_fixed_size 0
  .amdhsa_kernarg_size 48
  .amdhsa_user_sgpr_count 2
  .amdhsa_user_sgpr_kernarg_segment_ptr 1
  .amdhsa_system_sgpr_workgroup_id_x 1
.end_amdhsa_kernel
```
